```python
import torch

def _softmax(x, axis=-1):
    return torch.softmax(x, dim=axis)
def _gelu(x):
    return torch.nn.functional.gelu(x, approximate="tanh")
def _silu(x):
    return torch.nn.functional.silu(x)
def _sigmoid(x):
    return torch.sigmoid(x)
def _layernorm(x, axis=-1, eps=1e-5):
    m = x.mean(dim=axis, keepdim=True)
    v = x.var(dim=axis, keepdim=True, unbiased=False)
    return (x - m) / torch.sqrt(v + eps)
def _scatter_add(tgt, idx, src, axis=0):
    return tgt.clone().index_add_(axis, idx, src)
def _segment_sum(src, seg, n):
    out = torch.zeros((n,) + src.shape[1:], dtype=src.dtype)
    return out.index_add_(0, seg, src)
def _pad(x, pw):
    flat = tuple(v for pair in reversed(pw) for v in pair)
    return torch.nn.functional.pad(x, flat)

kernel_name = 'standalone__sliding_block_cached__decode'

def setup_inputs():

    _w = (lambda a: (lambda t: t.to(torch.bfloat16) if t.is_floating_point() else t)(torch.as_tensor(a)))
    B, Sq, D = 4, 1, 576
    Hq, Hkv, Sk, Dh = 32, 16, 8192, 128
    assert Hq % Hkv == 0, (Hq, Hkv)
    return {
        "x": _w((lambda *s: torch.randn(*s, dtype=torch.bfloat16) * 0.8)(B, Sq, D)),
        "k_cache": _w((lambda *s: torch.randn(*s, dtype=torch.bfloat16) * 0.8)(B, Hkv, Sk, Dh)),
        "v_cache": _w((lambda *s: torch.randn(*s, dtype=torch.bfloat16) * 0.05)(B, Hkv, Sk, Dh)),
        "wq": _w((lambda *s: torch.randn(*s, dtype=torch.bfloat16) * 0.8)(D, Hq * Dh) * (D ** -0.5)),
        "wo": _w((lambda *s: torch.randn(*s, dtype=torch.bfloat16) * 0.05)(Hq * Dh, D) * ((Hq * Dh) ** -0.5)),
    }

def reference(x, k_cache, v_cache, wq, wo):
    B, Sq, D = x.shape
    Hq, Dh = 32, 128
    Hkv, Sk = k_cache.shape[1], k_cache.shape[2]
    W = min(4096, max(256, Sk // 4))
    rep = Hq // Hkv
    q = (lambda x, *d: x.permute(*d))((x @ wq).reshape(B, Sq, Hq, Dh), 0, 2, 1, 3)
    k = (lambda x, n, axis: torch.repeat_interleave(x, n, dim=axis))(k_cache[:, :, Sk - W:, :], rep, axis=1)
    v = (lambda x, n, axis: torch.repeat_interleave(x, n, dim=axis))(v_cache[:, :, Sk - W:, :], rep, axis=1)
    scores = torch.einsum("bhqd,bhkd->bhqk", q, k) * (Dh ** -0.5)
    p = _softmax(scores, axis=-1)
    o = torch.einsum("bhqk,bhkd->bhqd", p, v)
    return (lambda x, *d: x.permute(*d))(o, 0, 2, 1, 3).reshape(B, Sq, Hq * Dh) @ wo
```

```asm
; @launch grid=(256,1,1) block=(1024,1,1) lds=160256
.amdgcn_target "amdgcn-amd-amdhsa--gfx950"
.text
.globl standalone__sliding_block_cached__decode_kernel
.p2align 8
.type standalone__sliding_block_cached__decode_kernel,@function
standalone__sliding_block_cached__decode_kernel:
    s_cmp_ge_u32 s2, 256
    s_cbranch_scc1 L_end
    s_load_dwordx16 s[4:19], s[0:1], 0
    v_lshrrev_b32 v1, 6, v0
    v_and_b32 v0, 63, v0
    v_readfirstlane_b32 s3, v1
    s_and_b32 s44, s2, 15
    s_lshr_b32 s51, s2, 4
    s_lshr_b32 s46, s51, 2
    s_and_b32 s47, s51, 3
    s_lshl_b32 s45, s46, 2
    s_add_u32 s45, s45, s47
    v_lshrrev_b32 v1, 3, v0
    v_lshlrev_b32 v1, 13, v1
    v_and_b32 v9, 7, v0
    v_lshl_add_u32 v9, v9, 4, v1
    v_add_u32 v127, 36, v0
    v_lshrrev_b32 v1, 3, v127
    v_lshlrev_b32 v1, 13, v1
    v_and_b32 v127, 7, v127
    v_lshl_add_u32 v127, v127, 4, v1
    v_lshlrev_b32 v4, 4, v0
    s_lshr_b32 s53, s45, 2
    s_mul_i32 s51, s53, 144
    s_mul_i32 s52, s3, 9
    s_add_u32 s51, s51, s52
    s_lshl_b32 s51, s51, 13
    s_lshl_b32 s52, s44, 9
    s_add_u32 s51, s51, s52
    s_and_b32 s52, s45, 3
    s_lshl_b32 s52, s52, 7
    s_add_u32 s51, s51, s52
    s_mul_i32 s52, s3, 1152
    s_add_u32 m0, s52, 10752
    s_mul_i32 s53, s53, 288
    s_mul_i32 s52, s3, 1152
    s_add_u32 s53, s53, s52
    s_mul_i32 s54, s3, 288
    s_waitcnt lgkmcnt(0)
    s_mov_b32 s28, s10
    s_and_b32 s29, s11, 0xffff
    s_mov_b32 s30, 4718592
    s_mov_b32 s31, 0x20000
    s_mov_b32 exec_lo, -1
    s_mov_b32 exec_hi, 0xf
    buffer_load_dwordx4 v9, s[28:31], s51 offen nt lds
    s_add_u32 m0, m0, 576
    s_mov_b32 s36, s4
    s_and_b32 s37, s5, 0xffff
    buffer_load_dwordx4 v127, s[28:31], s51 offen nt lds
    s_mov_b32 s38, 4608
    s_mov_b32 s39, 0x20000
    s_mov_b64 exec, -1
    s_cmp_lt_u32 s3, 4
    s_cbranch_scc0 L_nox
    s_add_u32 m0, s54, 6144
    s_mov_b32 exec_lo, 0x3ffff
    s_mov_b32 exec_hi, 0
    buffer_load_dwordx4 v4, s[36:39], s53 offen lds
    s_mov_b64 exec, -1
L_nox:
    v_mov_b32 v110, 0
    v_mov_b32 v111, 0
    v_mov_b32 v112, 0
    v_mov_b32 v113, 0
    s_cmp_eq_u32 s3, 0
    s_cbranch_scc0 L_i1
    global_load_dword v126, v110, s[18:19]
L_i1:
    s_cmp_eq_u32 s3, 1
    s_cbranch_scc0 L_i3
    ds_write_b128 v112, v[110:113] offset:0
    ds_write_b128 v112, v[110:113] offset:16
    s_waitcnt lgkmcnt(0)
L_i3:
    s_lshl_b32 s51, s46, 4
    s_add_u32 s51, s51, s44
    s_lshl_b32 s48, s51, 21
    s_lshl_b32 s51, s47, 17
    s_add_u32 s48, s48, s51
    s_add_u32 s48, s48, 0x180000
    s_lshl_b32 s51, s3, 13
    s_add_u32 s48, s48, s51
    s_add_u32 s55, s51, 29184
    s_lshr_b32 s49, s2, 3
    s_add_u32 s49, s49, s3
    v_and_b32 v2, 15, v0
    v_lshrrev_b32 v3, 4, v0
    v_xor_b32 v1, v2, v3
    v_lshlrev_b32 v1, 4, v1
    v_lshl_add_u32 v5, v3, 8, v1
    v_xor_b32 v6, 64, v5
    v_xor_b32 v7, 0x80, v5
    v_xor_b32 v8, 0xc0, v5
    s_mov_b32 s20, s6
    s_and_b32 s21, s7, 0xffff
    s_mov_b32 s22, 134217728
    s_mov_b32 s23, 0x20000
    s_mov_b32 s24, s8
    s_and_b32 s25, s9, 0xffff
    s_mov_b32 s26, 134217728
    s_mov_b32 s27, 0x20000
    s_getreg_b32 s16, hwreg(HW_REG_XCC_ID, 0, 4)
    s_mov_b32 s17, 0
    s_and_b32 s63, s44, 7
    s_lshl_b32 s63, s63, 3
    s_lshr_b32 s51, s44, 3
    s_lshl_b32 s51, s51, 2
    s_add_u32 s63, s63, s51
    s_add_u32 s63, s63, s46
    s_barrier
    s_cmp_eq_u32 s3, 4
    s_cbranch_scc0 L_nocpf
    s_cmp_lt_u32 s2, 16
    s_cbranch_scc0 L_nocpf
    s_getpc_b64 s[56:57]
L_pc:
    v_lshlrev_b32 v1, 7, v0
    v_min_u32 v1, L_end-L_pc, v1
    v_mov_b32 v111, s57
    v_add_co_u32 v110, vcc, s56, v1
    s_nop 1
    v_addc_co_u32 v111, vcc, 0, v111, vcc
    global_load_dword v112, v[110:111], off
L_nocpf:
    s_cmp_eq_u32 s3, 0
    s_cbranch_scc1 L_w0
    s_add_u32 s51, s49, 0
    s_and_b32 s51, s51, 7
    s_lshl_b32 s51, s51, 10
    s_add_u32 s51, s51, s48
    s_add_u32 m0, s55, 0
    s_nop 0
    buffer_load_dwordx4 v5, s[20:23], s51 offen nt lds
    s_mov_b32 s32, s12
    s_and_b32 s33, s13, 0xffff
    s_mov_b32 s34, 4718592
    s_mov_b32 s35, 0x20000
    s_mov_b32 s40, s14
    s_and_b32 s41, s15, 0xffff
    s_mov_b32 s42, 4608
    s_mov_b32 s43, 0x20000
    s_waitcnt vmcnt(1)
    v_mov_b32 v1, 0
    v_mov_b32 v110, 1
    s_mov_b64 exec, 1
    ds_add_u32 v1, v110 offset:20
    s_mov_b64 exec, -1
    s_add_u32 s51, s49, 1
    s_and_b32 s51, s51, 7
    s_lshl_b32 s51, s51, 10
    s_add_u32 s51, s51, s48
    s_add_u32 m0, s55, 1024
    s_nop 0
    buffer_load_dwordx4 v6, s[20:23], s51 offen nt lds
    s_add_u32 s51, s49, 2
    s_and_b32 s51, s51, 7
    s_lshl_b32 s51, s51, 10
    s_add_u32 s51, s51, s48
    s_add_u32 m0, s55, 2048
    s_nop 0
    buffer_load_dwordx4 v7, s[20:23], s51 offen nt lds
    s_waitcnt vmcnt(2)
    s_add_u32 s51, s49, 3
    s_and_b32 s51, s51, 7
    s_lshl_b32 s51, s51, 10
    s_add_u32 s51, s51, s48
    s_add_u32 m0, s55, 3072
    s_nop 0
    buffer_load_dwordx4 v8, s[20:23], s51 offen nt lds
    s_waitcnt vmcnt(2)
    s_add_u32 s51, s49, 4
    s_and_b32 s51, s51, 7
    s_lshl_b32 s51, s51, 10
    s_add_u32 s51, s51, s48
    s_add_u32 m0, s55, 4096
    s_nop 0
    buffer_load_dwordx4 v5, s[20:23], s51 offen nt lds
    s_waitcnt vmcnt(2)
    s_add_u32 s51, s49, 5
    s_and_b32 s51, s51, 7
    s_lshl_b32 s51, s51, 10
    s_add_u32 s51, s51, s48
    s_add_u32 m0, s55, 5120
    s_nop 0
    buffer_load_dwordx4 v6, s[20:23], s51 offen nt lds
    s_waitcnt vmcnt(2)
    s_add_u32 s51, s49, 6
    s_and_b32 s51, s51, 7
    s_lshl_b32 s51, s51, 10
    s_add_u32 s51, s51, s48
    s_add_u32 m0, s55, 6144
    s_nop 0
    buffer_load_dwordx4 v7, s[20:23], s51 offen nt lds
    s_waitcnt vmcnt(2)
    s_add_u32 s51, s49, 7
    s_and_b32 s51, s51, 7
    s_lshl_b32 s51, s51, 10
    s_add_u32 s51, s51, s48
    s_add_u32 m0, s55, 7168
    s_nop 0
    buffer_load_dwordx4 v8, s[20:23], s51 offen nt lds
    s_waitcnt vmcnt(2)
    s_add_u32 s51, s49, 0
    s_and_b32 s51, s51, 7
    s_lshl_b32 s51, s51, 10
    s_add_u32 s51, s51, s48
    buffer_load_dwordx4 v[10:13], v4, s[24:27], s51 offen nt
    s_waitcnt vmcnt(2)
    s_add_u32 s51, s49, 1
    s_and_b32 s51, s51, 7
    s_lshl_b32 s51, s51, 10
    s_add_u32 s51, s51, s48
    buffer_load_dwordx4 v[14:17], v4, s[24:27], s51 offen nt
    s_waitcnt vmcnt(2)
    s_add_u32 s51, s49, 2
    s_and_b32 s51, s51, 7
    s_lshl_b32 s51, s51, 10
    s_add_u32 s51, s51, s48
    buffer_load_dwordx4 v[18:21], v4, s[24:27], s51 offen nt
    s_waitcnt vmcnt(3)
    v_xor_b32 v1, v2, v3
    v_lshlrev_b32 v1, 4, v1
    v_lshl_add_u32 v1, v2, 8, v1
    v_add_u32 v110, s55, v1
    v_xor_b32 v111, 64, v110
    v_xor_b32 v112, 0x80, v110
    v_xor_b32 v113, 0xc0, v110
    ds_read_b128 v[42:45], v110 offset:0
    ds_read_b128 v[46:49], v111 offset:0
    ds_read_b128 v[50:53], v112 offset:0
    ds_read_b128 v[54:57], v113 offset:0
    ds_read_b128 v[58:61], v110 offset:4096
    ds_read_b128 v[62:65], v111 offset:4096
    ds_read_b128 v[66:69], v112 offset:4096
    ds_read_b128 v[70:73], v113 offset:4096
    v_and_b32 v1, 1, v0
    v_cmp_eq_u32 vcc, 1, v1
    v_mov_b32 v114, 0x0c0c0100
    v_mov_b32 v115, 0x01000c0c
    v_mov_b32 v116, 0x0c0c0302
    v_mov_b32 v117, 0x03020c0c
    v_cndmask_b32 v114, v114, v115, vcc
    v_cndmask_b32 v116, v116, v117, vcc
    v_mov_b32 v115, 0x0c0c0c0c
    v_bfe_u32 v1, v0, 1, 2
    v_cmp_eq_u32 vcc, 0, v1
    v_mov_b32 v90, 0
    v_mov_b32 v91, 0
    v_cndmask_b32 v102, v115, v114, vcc
    v_cndmask_b32 v106, v115, v116, vcc
    v_cmp_eq_u32 vcc, 1, v1
    v_mov_b32 v92, 0
    v_mov_b32 v93, 0
    v_cndmask_b32 v103, v115, v114, vcc
    v_cndmask_b32 v107, v115, v116, vcc
    v_cmp_eq_u32 vcc, 2, v1
    v_mov_b32 v94, 0
    v_mov_b32 v95, 0
    v_cndmask_b32 v104, v115, v114, vcc
    v_cndmask_b32 v108, v115, v116, vcc
    v_cmp_eq_u32 vcc, 3, v1
    v_mov_b32 v96, 0
    v_mov_b32 v97, 0
    v_cndmask_b32 v105, v115, v114, vcc
    v_cndmask_b32 v109, v115, v116, vcc
    v_and_b32 v1, 1, v0
    v_lshlrev_b32 v1, 8, v1
    v_lshl_add_u32 v120, v3, 4, v1
    v_lshrrev_b32 v1, 5, v0
    v_lshlrev_b32 v121, 2, v1
    v_and_b32 v122, 3, v0
    v_lshlrev_b32 v122, 4, v122
    v_bfe_u32 v123, v0, 2, 3
    v_lshl_add_u32 v122, v123, 1, v122
    v_lshl_add_u32 v122, v1, 6, v122
    s_lshl_b32 s52, s3, 7
    s_add_u32 s52, s52, 768
    v_add_u32 v122, s52, v122
    v_lshrrev_b32 v123, 3, v2
    v_lshlrev_b32 v123, 6, v123
    v_lshl_add_u32 v123, v3, 4, v123
    v_add_u32 v123, s52, v123
    v_mov_b32 v98, 0
    v_mov_b32 v99, 0
    v_mov_b32 v100, 0
    v_mov_b32 v101, 0
    v_cmp_le_u32 vcc, 18, v0
    v_mov_b32 v1, 0
    v_mov_b32 v124, 864
    v_cndmask_b32 v1, v1, v124, vcc
    v_add_u32 v124, v1, v4
    s_cmp_lt_u32 s3, 0
    s_cbranch_scc0 L_np1_0
    s_mul_i32 s51, s47, 294912
    s_lshl_b32 s52, s3, 13
    s_add_u32 s51, s51, s52
    s_lshl_b32 s52, s63, 7
    s_add_u32 s51, s51, s52
    s_add_u32 s51, s51, 1114112
    v_mul_u32_u24 v116, 73728, v0
    v_add_u32 v116, s51, v116
    s_mov_b64 exec, 0xf
    global_load_dword v9, v116, s[18:19]
    s_mov_b64 exec, -1
    s_branch L_np2_0
L_np1_0:
    s_cmp_eq_u32 s3, 99
    s_cbranch_scc0 L_np3_0
    s_lshl_b32 s51, s44, 4
    s_add_u32 s51, s51, s45
    s_lshl_b32 s52, s51, 10
    s_add_u32 s52, s52, 65536
    v_lshlrev_b32 v116, 7, v0
    v_add_u32 v116, s52, v116
    s_mov_b64 exec, 0xff
    global_load_dword v9, v116, s[18:19]
    s_mov_b64 exec, -1
    s_branch L_np2_0
L_np3_0:
    s_cmp_eq_u32 s3, 15
    s_cbranch_scc0 L_np2_0
    s_cmp_lt_u32 s2, 144
    s_cbranch_scc0 L_np2_0
    s_and_b32 s51, s2, 3
    s_bfe_u32 s52, s2, 0x20002
    s_lshr_b32 s53, s2, 4
    s_mul_i32 s52, s52, 1152
    s_mul_i32 s51, s51, 288
    s_add_u32 s52, s52, s51
    s_lshl_b32 s53, s53, 5
    s_add_u32 s52, s52, s53
    v_mov_b32 v116, s52
    s_mov_b64 exec, 1
    buffer_load_dword v9, v116, s[40:43], 0 offen
    s_mov_b64 exec, -1
L_np2_0:
    s_branch L_bar2
L_w0:
    s_add_u32 s51, s49, 0
    s_and_b32 s51, s51, 7
    s_lshl_b32 s51, s51, 10
    s_add_u32 s51, s51, s48
    s_add_u32 m0, s55, 0
    s_nop 0
    buffer_load_dwordx4 v5, s[20:23], s51 offen nt lds
    s_mov_b32 s32, s12
    s_and_b32 s33, s13, 0xffff
    s_mov_b32 s34, 4718592
    s_mov_b32 s35, 0x20000
    s_mov_b32 s40, s14
    s_and_b32 s41, s15, 0xffff
    s_mov_b32 s42, 4608
    s_mov_b32 s43, 0x20000
    v_and_b32 v1, 3, v0
    v_mul_u32_u24 v1, 288, v1
    v_lshl_add_u32 v42, v3, 4, v1
    v_add_u32 v42, 6144, v42
    v_lshl_add_u32 v43, v3, 3, v1
    v_add_u32 v43, 6400, v43
    v_lshrrev_b32 v1, 2, v2
    v_lshl_add_u32 v120, v3, 3, v1
    v_lshlrev_b32 v120, 7, v120
    v_lshl_add_u32 v121, v3, 2, v1
    v_lshlrev_b32 v121, 7, v121
    v_and_b32 v1, 3, v0
    v_lshl_add_u32 v120, v1, 3, v120
    v_lshl_add_u32 v121, v1, 3, v121
    v_add_u32 v120, 10752, v120
    v_add_u32 v121, 27136, v121
    v_mov_b32 v44, 0
    v_mov_b32 v45, 0
    v_mov_b32 v46, 0
    v_mov_b32 v47, 0
    v_mov_b32 v48, 0
    v_mov_b32 v49, 0
    v_mov_b32 v50, 0
    v_mov_b32 v51, 0
    v_mov_b32 v52, 0
    v_mov_b32 v53, 0
    v_mov_b32 v54, 0
    v_mov_b32 v55, 0
    v_mov_b32 v56, 0
    v_mov_b32 v57, 0
    v_mov_b32 v58, 0
    v_mov_b32 v59, 0
    v_mov_b32 v1, 0
    s_mov_b32 s53, 0
    s_waitcnt vmcnt(1)
    v_readfirstlane_b32 s50, v126
    s_mul_i32 s50, s50, 1664525
    s_add_u32 s50, s50, 1013904223
L_cnt:
    ds_read_b32 v110, v1 offset:20
    s_add_u32 s53, s53, 1
    s_waitcnt lgkmcnt(0)
    v_readfirstlane_b32 s51, v110
    s_cmp_ge_u32 s53, 800000
    s_cbranch_scc1 L_cntok
    s_cmp_lt_u32 s51, 15
    s_cbranch_scc1 L_cnt
L_cntok:
    ds_read_b128 v[60:63], v42 offset:0
    ds_read_b128 v[64:67], v42 offset:64
    ds_read_b128 v[68:71], v42 offset:128
    ds_read_b128 v[72:75], v42 offset:192
    ds_read_b64 v[76:77], v43
    ds_read_b64_tr_b16 v[78:79], v120 offset:0
    ds_read_b64_tr_b16 v[80:81], v120 offset:512
    ds_read_b64_tr_b16 v[82:83], v120 offset:32
    ds_read_b64_tr_b16 v[84:85], v120 offset:544
    ds_read_b64_tr_b16 v[86:87], v120 offset:64
    ds_read_b64_tr_b16 v[88:89], v120 offset:576
    ds_read_b64_tr_b16 v[90:91], v120 offset:96
    ds_read_b64_tr_b16 v[92:93], v120 offset:608
    s_waitcnt lgkmcnt(0)
    ds_read_b64_tr_b16 v[94:95], v120 offset:4096
    ds_read_b64_tr_b16 v[96:97], v120 offset:4608
    ds_read_b64_tr_b16 v[98:99], v120 offset:4128
    ds_read_b64_tr_b16 v[100:101], v120 offset:4640
    ds_read_b64_tr_b16 v[102:103], v120 offset:4160
    ds_read_b64_tr_b16 v[104:105], v120 offset:4672
    ds_read_b64_tr_b16 v[106:107], v120 offset:4192
    ds_read_b64_tr_b16 v[108:109], v120 offset:4704
    v_mfma_f32_16x16x32_bf16 v[44:47], v[60:63], v[78:81], v[44:47]
    v_mfma_f32_16x16x32_bf16 v[48:51], v[60:63], v[82:85], v[48:51]
    v_mfma_f32_16x16x32_bf16 v[52:55], v[60:63], v[86:89], v[52:55]
    v_mfma_f32_16x16x32_bf16 v[56:59], v[60:63], v[90:93], v[56:59]
    s_waitcnt lgkmcnt(0)
    ds_read_b64_tr_b16 v[78:79], v120 offset:8192
    ds_read_b64_tr_b16 v[80:81], v120 offset:8704
    ds_read_b64_tr_b16 v[82:83], v120 offset:8224
    ds_read_b64_tr_b16 v[84:85], v120 offset:8736
    ds_read_b64_tr_b16 v[86:87], v120 offset:8256
    ds_read_b64_tr_b16 v[88:89], v120 offset:8768
    ds_read_b64_tr_b16 v[90:91], v120 offset:8288
    ds_read_b64_tr_b16 v[92:93], v120 offset:8800
    v_mfma_f32_16x16x32_bf16 v[44:47], v[64:67], v[94:97], v[44:47]
    v_mfma_f32_16x16x32_bf16 v[48:51], v[64:67], v[98:101], v[48:51]
    v_mfma_f32_16x16x32_bf16 v[52:55], v[64:67], v[102:105], v[52:55]
    v_mfma_f32_16x16x32_bf16 v[56:59], v[64:67], v[106:109], v[56:59]
    s_waitcnt lgkmcnt(0)
    ds_read_b64_tr_b16 v[94:95], v120 offset:12288
    ds_read_b64_tr_b16 v[96:97], v120 offset:12800
    ds_read_b64_tr_b16 v[98:99], v120 offset:12320
    ds_read_b64_tr_b16 v[100:101], v120 offset:12832
    ds_read_b64_tr_b16 v[102:103], v120 offset:12352
    ds_read_b64_tr_b16 v[104:105], v120 offset:12864
    ds_read_b64_tr_b16 v[106:107], v120 offset:12384
    ds_read_b64_tr_b16 v[108:109], v120 offset:12896
    v_mfma_f32_16x16x32_bf16 v[44:47], v[68:71], v[78:81], v[44:47]
    v_mfma_f32_16x16x32_bf16 v[48:51], v[68:71], v[82:85], v[48:51]
    v_mfma_f32_16x16x32_bf16 v[52:55], v[68:71], v[86:89], v[52:55]
    v_mfma_f32_16x16x32_bf16 v[56:59], v[68:71], v[90:93], v[56:59]
    s_waitcnt lgkmcnt(0)
    ds_read_b64_tr_b16 v[78:79], v121 offset:0
    ds_read_b64_tr_b16 v[80:81], v121 offset:32
    ds_read_b64_tr_b16 v[82:83], v121 offset:64
    ds_read_b64_tr_b16 v[84:85], v121 offset:96
    v_mfma_f32_16x16x32_bf16 v[44:47], v[72:75], v[94:97], v[44:47]
    v_mfma_f32_16x16x32_bf16 v[48:51], v[72:75], v[98:101], v[48:51]
    v_mfma_f32_16x16x32_bf16 v[52:55], v[72:75], v[102:105], v[52:55]
    v_mfma_f32_16x16x32_bf16 v[56:59], v[72:75], v[106:109], v[56:59]
    s_waitcnt lgkmcnt(0)
    v_mfma_f32_16x16x16_bf16 v[44:47], v[76:77], v[78:79], v[44:47]
    v_mfma_f32_16x16x16_bf16 v[48:51], v[76:77], v[80:81], v[48:51]
    v_mfma_f32_16x16x16_bf16 v[52:55], v[76:77], v[82:83], v[52:55]
    v_mfma_f32_16x16x16_bf16 v[56:59], v[76:77], v[84:85], v[56:59]
    s_mov_b32 s56, 0xffff0000
    s_mov_b32 s57, 0
    s_mov_b32 s58, 0
    s_mov_b32 s59, 0xffff
    s_mov_b32 s60, 0
    s_mov_b32 s61, 0xffff0000
    s_lshl_b32 s51, s44, 14
    s_lshl_b32 s52, s45, 8
    s_add_u32 s51, s51, s52
    s_add_u32 s51, s51, 589824
    v_lshlrev_b32 v78, 12, v3
    v_lshl_add_u32 v78, v2, 4, v78
    v_add_u32 v78, s51, v78
    s_and_b32 s53, s50, -16
    s_or_b32 s53, s53, s16
    v_mov_b32 v79, 0xffffff00
    v_cndmask_b32 v60, v44, v45, s[56:57]
    v_cndmask_b32 v60, v60, v46, s[58:59]
    v_cndmask_b32 v60, v60, v47, s[60:61]
    s_bfe_u32 s52, s53, 0x80000
    v_and_or_b32 v60, v60, v79, s52
    v_cndmask_b32 v61, v48, v49, s[56:57]
    v_cndmask_b32 v61, v61, v50, s[58:59]
    v_cndmask_b32 v61, v61, v51, s[60:61]
    s_bfe_u32 s52, s53, 0x80008
    v_and_or_b32 v61, v61, v79, s52
    v_cndmask_b32 v62, v52, v53, s[56:57]
    v_cndmask_b32 v62, v62, v54, s[58:59]
    v_cndmask_b32 v62, v62, v55, s[60:61]
    s_bfe_u32 s52, s53, 0x80010
    v_and_or_b32 v62, v62, v79, s52
    v_cndmask_b32 v63, v56, v57, s[56:57]
    v_cndmask_b32 v63, v63, v58, s[58:59]
    v_cndmask_b32 v63, v63, v59, s[60:61]
    s_bfe_u32 s52, s53, 0x80018
    v_and_or_b32 v63, v63, v79, s52
    global_store_dwordx4 v78, v[60:63], s[18:19] sc1
    s_add_u32 s51, s49, 1
    s_and_b32 s51, s51, 7
    s_lshl_b32 s51, s51, 10
    s_add_u32 s51, s51, s48
    s_add_u32 m0, s55, 1024
    s_nop 0
    buffer_load_dwordx4 v6, s[20:23], s51 offen nt lds
    s_add_u32 s51, s49, 2
    s_and_b32 s51, s51, 7
    s_lshl_b32 s51, s51, 10
    s_add_u32 s51, s51, s48
    s_add_u32 m0, s55, 2048
    s_nop 0
    buffer_load_dwordx4 v7, s[20:23], s51 offen nt lds
    s_add_u32 s51, s49, 3
    s_and_b32 s51, s51, 7
    s_lshl_b32 s51, s51, 10
    s_add_u32 s51, s51, s48
    s_add_u32 m0, s55, 3072
    s_nop 0
    buffer_load_dwordx4 v8, s[20:23], s51 offen nt lds
    s_add_u32 s51, s49, 4
    s_and_b32 s51, s51, 7
    s_lshl_b32 s51, s51, 10
    s_add_u32 s51, s51, s48
    s_add_u32 m0, s55, 4096
    s_nop 0
    buffer_load_dwordx4 v5, s[20:23], s51 offen nt lds
    s_add_u32 s51, s49, 5
    s_and_b32 s51, s51, 7
    s_lshl_b32 s51, s51, 10
    s_add_u32 s51, s51, s48
    s_add_u32 m0, s55, 5120
    s_nop 0
    buffer_load_dwordx4 v6, s[20:23], s51 offen nt lds
    s_add_u32 s51, s49, 6
    s_and_b32 s51, s51, 7
    s_lshl_b32 s51, s51, 10
    s_add_u32 s51, s51, s48
    s_add_u32 m0, s55, 6144
    s_nop 0
    buffer_load_dwordx4 v7, s[20:23], s51 offen nt lds
    s_add_u32 s51, s49, 7
    s_and_b32 s51, s51, 7
    s_lshl_b32 s51, s51, 10
    s_add_u32 s51, s51, s48
    s_add_u32 m0, s55, 7168
    s_nop 0
    buffer_load_dwordx4 v8, s[20:23], s51 offen nt lds
    s_add_u32 s51, s49, 0
    s_and_b32 s51, s51, 7
    s_lshl_b32 s51, s51, 10
    s_add_u32 s51, s51, s48
    buffer_load_dwordx4 v[10:13], v4, s[24:27], s51 offen nt
    s_add_u32 s51, s49, 1
    s_and_b32 s51, s51, 7
    s_lshl_b32 s51, s51, 10
    s_add_u32 s51, s51, s48
    buffer_load_dwordx4 v[14:17], v4, s[24:27], s51 offen nt
    s_add_u32 s51, s49, 2
    s_and_b32 s51, s51, 7
    s_lshl_b32 s51, s51, 10
    s_add_u32 s51, s51, s48
    buffer_load_dwordx4 v[18:21], v4, s[24:27], s51 offen nt
    s_mov_b64 exec, 1
    buffer_load_dword v125, v4, s[40:43], 0 offen
    s_mov_b64 exec, -1
    s_lshl_b32 s51, s44, 14
    s_lshl_b32 s52, s46, 12
    s_add_u32 s51, s51, s52
    s_add_u32 s51, s51, 589824
    v_add_u32 v110, s51, v4
    s_mov_b32 s56, 0x0c0c0400
    s_mov_b32 s57, 0x04000c0c
    s_mov_b32 s62, 15
    s_mov_b32 s53, 0
    v_mov_b32 v79, s50
L_qd_round:
    s_bitcmp1_b32 s62, 0
    s_cbranch_scc0 L_qd_s0
    global_load_dwordx4 v[44:47], v110, s[18:19] offset:0 sc1
L_qd_s0:
    s_bitcmp1_b32 s62, 1
    s_cbranch_scc0 L_qd_s1
    global_load_dwordx4 v[48:51], v110, s[18:19] offset:1024 sc1
L_qd_s1:
    s_bitcmp1_b32 s62, 2
    s_cbranch_scc0 L_qd_s2
    global_load_dwordx4 v[52:55], v110, s[18:19] offset:2048 sc1
L_qd_s2:
    s_bitcmp1_b32 s62, 3
    s_cbranch_scc0 L_qd_s3
    global_load_dwordx4 v[56:59], v110, s[18:19] offset:3072 sc1
L_qd_s3:
    s_add_u32 s53, s53, 1
    s_waitcnt vmcnt(0)
    v_perm_b32 v76, v45, v44, s56
    v_perm_b32 v77, v47, v46, s57
    v_or_b32 v80, v76, v77
    v_xor_b32 v76, v79, v80
    v_and_b32 v76, -16, v76
    v_cmp_ne_u32 vcc, 0, v76
    s_nop 0
    s_cmp_lg_u64 vcc, 0
    s_cbranch_scc1 L_qd_c0
    s_bitset0_b32 s62, 0
L_qd_c0:
    v_perm_b32 v76, v49, v48, s56
    v_perm_b32 v77, v51, v50, s57
    v_or_b32 v81, v76, v77
    v_xor_b32 v76, v79, v81
    v_and_b32 v76, -16, v76
    v_cmp_ne_u32 vcc, 0, v76
    s_nop 0
    s_cmp_lg_u64 vcc, 0
    s_cbranch_scc1 L_qd_c1
    s_bitset0_b32 s62, 1
L_qd_c1:
    v_perm_b32 v76, v53, v52, s56
    v_perm_b32 v77, v55, v54, s57
    v_or_b32 v82, v76, v77
    v_xor_b32 v76, v79, v82
    v_and_b32 v76, -16, v76
    v_cmp_ne_u32 vcc, 0, v76
    s_nop 0
    s_cmp_lg_u64 vcc, 0
    s_cbranch_scc1 L_qd_c2
    s_bitset0_b32 s62, 2
L_qd_c2:
    v_perm_b32 v76, v57, v56, s56
    v_perm_b32 v77, v59, v58, s57
    v_or_b32 v83, v76, v77
    v_xor_b32 v76, v79, v83
    v_and_b32 v76, -16, v76
    v_cmp_ne_u32 vcc, 0, v76
    s_nop 0
    s_cmp_lg_u64 vcc, 0
    s_cbranch_scc1 L_qd_c3
    s_bitset0_b32 s62, 3
L_qd_c3:
    s_cmp_eq_u32 s62, 0
    s_cbranch_scc1 L_qd_done
    s_cmp_lt_u32 s53, 100000
    s_cbranch_scc1 L_qd_round
L_qd_done:
    s_and_b32 s51, s50, -16
    s_or_b32 s51, s51, s16
    v_cmp_eq_u32 vcc, s51, v80
    v_cmp_eq_u32 s[56:57], s51, v81
    v_cmp_eq_u32 s[58:59], s51, v82
    v_cmp_eq_u32 s[60:61], s51, v83
    s_nop 1
    s_and_b64 vcc, vcc, s[56:57]
    s_and_b64 s[58:59], s[58:59], s[60:61]
    s_and_b64 vcc, vcc, s[58:59]
    s_cmp_eq_u64 vcc, -1
    s_cselect_b32 s17, 1, 0
    v_add_f32 v44, v44, v48
    v_add_f32 v52, v52, v56
    v_add_f32 v45, v45, v49
    v_add_f32 v53, v53, v57
    v_add_f32 v46, v46, v50
    v_add_f32 v54, v54, v58
    v_add_f32 v47, v47, v51
    v_add_f32 v55, v55, v59
    v_add_f32 v44, v44, v52
    v_add_f32 v45, v45, v53
    v_add_f32 v46, v46, v54
    v_add_f32 v47, v47, v55
    v_cvt_pk_bf16_f32 v44, v44, v45
    v_cvt_pk_bf16_f32 v46, v46, v47
    v_lshlrev_b32 v1, 7, v3
    v_lshl_add_u32 v1, v2, 1, v1
    ds_write_b16 v1, v44 offset:256
    ds_write_b16_d16_hi v1, v44 offset:288
    ds_write_b16 v1, v46 offset:320
    ds_write_b16_d16_hi v1, v46 offset:352
    v_mov_b32 v1, 0
    v_mov_b32 v57, s50
    s_add_u32 s51, s17, 1
    v_mov_b32 v58, s51
    ds_write_b32 v1, v57 offset:16
    ds_write_b32 v1, v58 offset:24
    v_xor_b32 v1, v2, v3
    v_lshlrev_b32 v1, 4, v1
    v_lshl_add_u32 v1, v2, 8, v1
    v_add_u32 v110, s55, v1
    v_xor_b32 v111, 64, v110
    v_xor_b32 v112, 0x80, v110
    v_xor_b32 v113, 0xc0, v110
    ds_read_b128 v[42:45], v110 offset:0
    ds_read_b128 v[46:49], v111 offset:0
    ds_read_b128 v[50:53], v112 offset:0
    ds_read_b128 v[54:57], v113 offset:0
    ds_read_b128 v[58:61], v110 offset:4096
    ds_read_b128 v[62:65], v111 offset:4096
    ds_read_b128 v[66:69], v112 offset:4096
    ds_read_b128 v[70:73], v113 offset:4096
    v_and_b32 v1, 1, v0
    v_cmp_eq_u32 vcc, 1, v1
    v_mov_b32 v114, 0x0c0c0100
    v_mov_b32 v115, 0x01000c0c
    v_mov_b32 v116, 0x0c0c0302
    v_mov_b32 v117, 0x03020c0c
    v_cndmask_b32 v114, v114, v115, vcc
    v_cndmask_b32 v116, v116, v117, vcc
    v_mov_b32 v115, 0x0c0c0c0c
    v_bfe_u32 v1, v0, 1, 2
    v_cmp_eq_u32 vcc, 0, v1
    v_mov_b32 v90, 0
    v_mov_b32 v91, 0
    v_cndmask_b32 v102, v115, v114, vcc
    v_cndmask_b32 v106, v115, v116, vcc
    v_cmp_eq_u32 vcc, 1, v1
    v_mov_b32 v92, 0
    v_mov_b32 v93, 0
    v_cndmask_b32 v103, v115, v114, vcc
    v_cndmask_b32 v107, v115, v116, vcc
    v_cmp_eq_u32 vcc, 2, v1
    v_mov_b32 v94, 0
    v_mov_b32 v95, 0
    v_cndmask_b32 v104, v115, v114, vcc
    v_cndmask_b32 v108, v115, v116, vcc
    v_cmp_eq_u32 vcc, 3, v1
    v_mov_b32 v96, 0
    v_mov_b32 v97, 0
    v_cndmask_b32 v105, v115, v114, vcc
    v_cndmask_b32 v109, v115, v116, vcc
    v_and_b32 v1, 1, v0
    v_lshlrev_b32 v1, 8, v1
    v_lshl_add_u32 v120, v3, 4, v1
    v_lshrrev_b32 v1, 5, v0
    v_lshlrev_b32 v121, 2, v1
    v_and_b32 v122, 3, v0
    v_lshlrev_b32 v122, 4, v122
    v_bfe_u32 v123, v0, 2, 3
    v_lshl_add_u32 v122, v123, 1, v122
    v_lshl_add_u32 v122, v1, 6, v122
    s_lshl_b32 s52, s3, 7
    s_add_u32 s52, s52, 768
    v_add_u32 v122, s52, v122
    v_lshrrev_b32 v123, 3, v2
    v_lshlrev_b32 v123, 6, v123
    v_lshl_add_u32 v123, v3, 4, v123
    v_add_u32 v123, s52, v123
    v_mov_b32 v98, 0
    v_mov_b32 v99, 0
    v_mov_b32 v100, 0
    v_mov_b32 v101, 0
    v_cmp_le_u32 vcc, 18, v0
    v_mov_b32 v1, 0
    v_mov_b32 v124, 864
    v_cndmask_b32 v1, v1, v124, vcc
    v_add_u32 v124, v1, v4
    s_cmp_lt_u32 s3, 0
    s_cbranch_scc0 L_np1_1
    s_mul_i32 s51, s47, 294912
    s_lshl_b32 s52, s3, 13
    s_add_u32 s51, s51, s52
    s_lshl_b32 s52, s63, 7
    s_add_u32 s51, s51, s52
    s_add_u32 s51, s51, 1114112
    v_mul_u32_u24 v116, 73728, v0
    v_add_u32 v116, s51, v116
    s_mov_b64 exec, 0xf
    global_load_dword v9, v116, s[18:19]
    s_mov_b64 exec, -1
    s_branch L_np2_1
L_np1_1:
    s_cmp_eq_u32 s3, 99
    s_cbranch_scc0 L_np3_1
    s_lshl_b32 s51, s44, 4
    s_add_u32 s51, s51, s45
    s_lshl_b32 s52, s51, 10
    s_add_u32 s52, s52, 65536
    v_lshlrev_b32 v116, 7, v0
    v_add_u32 v116, s52, v116
    s_mov_b64 exec, 0xff
    global_load_dword v9, v116, s[18:19]
    s_mov_b64 exec, -1
    s_branch L_np2_1
L_np3_1:
    s_cmp_eq_u32 s3, 15
    s_cbranch_scc0 L_np2_1
    s_cmp_lt_u32 s2, 144
    s_cbranch_scc0 L_np2_1
    s_and_b32 s51, s2, 3
    s_bfe_u32 s52, s2, 0x20002
    s_lshr_b32 s53, s2, 4
    s_mul_i32 s52, s52, 1152
    s_mul_i32 s51, s51, 288
    s_add_u32 s52, s52, s51
    s_lshl_b32 s53, s53, 5
    s_add_u32 s52, s52, s53
    v_mov_b32 v116, s52
    s_mov_b64 exec, 1
    buffer_load_dword v9, v116, s[40:43], 0 offen
    s_mov_b64 exec, -1
L_np2_1:
    s_waitcnt lgkmcnt(0)
    s_branch L_qready
L_bar2:
    v_mov_b32 v1, 0
    s_mov_b32 s53, 0
L_qflag:
    ds_read_b32 v126, v1 offset:24
    s_add_u32 s53, s53, 1
    s_waitcnt lgkmcnt(0)
    v_readfirstlane_b32 s51, v126
    s_cmp_ge_u32 s53, 800000
    s_cbranch_scc1 L_qflag_ok
    s_cmp_lt_u32 s51, 1
    s_cbranch_scc1 L_qflag
L_qflag_ok:
    s_sub_u32 s17, s51, 1
L_qready:
    s_cmp_eq_u32 s3, 9
    s_cbranch_scc0 L_noot
    s_cmp_eq_u32 s17, 1
    s_cbranch_scc1 L_noot
    s_lshl_b32 s51, s44, 4
    s_add_u32 s51, s51, s45
    s_lshl_b32 s52, s51, 10
    s_add_u32 s52, s52, 65536
    v_lshlrev_b32 v116, 7, v0
    v_add_u32 v116, s52, v116
    s_mov_b64 exec, 0xff
    global_load_dword v9, v116, s[18:19]
    s_mov_b64 exec, -1
L_noot:
    ds_read_b128 v[74:77], v120 offset:256
    ds_read_b128 v[78:81], v120 offset:320
    ds_read_b128 v[82:85], v120 offset:384
    ds_read_b128 v[86:89], v120 offset:448
    v_mov_b32 v1, 0
    ds_read_b32 v126, v1 offset:16
    s_waitcnt lgkmcnt(1)
    v_mfma_f32_16x16x32_bf16 v[90:93], v[74:77], v[42:45], v[90:93]
    v_mfma_f32_16x16x32_bf16 v[94:97], v[74:77], v[58:61], v[94:97]
    v_mfma_f32_16x16x32_bf16 v[90:93], v[78:81], v[46:49], v[90:93]
    v_mfma_f32_16x16x32_bf16 v[94:97], v[78:81], v[62:65], v[94:97]
    v_mfma_f32_16x16x32_bf16 v[90:93], v[82:85], v[50:53], v[90:93]
    v_mfma_f32_16x16x32_bf16 v[94:97], v[82:85], v[66:69], v[94:97]
    v_mfma_f32_16x16x32_bf16 v[90:93], v[86:89], v[54:57], v[90:93]
    v_mfma_f32_16x16x32_bf16 v[94:97], v[86:89], v[70:73], v[94:97]
    s_mov_b32 s56, 0xffff0000
    s_mov_b32 s57, 0xffff0000
    s_mov_b32 s58, 0
    s_mov_b32 s59, -1
    s_mov_b32 s54, 0x3fb8aa3b
    s_waitcnt lgkmcnt(0)
    v_readfirstlane_b32 s50, v126
    s_nop 1
    v_cndmask_b32 v110, v90, v94, s[56:57]
    v_cndmask_b32 v111, v91, v95, s[56:57]
    v_cndmask_b32 v110, v110, v111, s[58:59]
    v_cvt_pk_bf16_f32 v110, v110, v110
    v_lshlrev_b32 v110, 16, v110
    v_mul_f32 v110, 0x3db504f3, v110
    v_cvt_pk_bf16_f32 v110, v110, v110
    v_lshlrev_b32 v110, 16, v110
    s_nop 1
    v_max_f32_dpp v111, v110, v110 row_ror:8 row_mask:0xf bank_mask:0xf
    s_nop 1
    v_max_f32_dpp v111, v111, v111 row_ror:4 row_mask:0xf bank_mask:0xf
    s_nop 1
    v_max_f32_dpp v111, v111, v111 row_ror:2 row_mask:0xf bank_mask:0xf
    s_nop 1
    v_max_f32_dpp v111, v111, v111 row_ror:1 row_mask:0xf bank_mask:0xf
    s_nop 0
    v_mov_b32 v112, v111
    s_nop 1
    v_permlane16_swap_b32 v111, v112
    s_nop 1
    v_max_f32 v111, v111, v112
    s_lshl_b32 s52, s3, 2
    v_lshl_add_u32 v112, v121, 4, s52
    v_mov_b32 v114, 1
    v_mov_b32 v113, 0
    s_mov_b32 exec_lo, 1
    s_mov_b32 exec_hi, 1
    ds_write_b32 v112, v111 offset:5120
    s_nop 0
    s_nop 0
    s_mov_b64 exec, -1
    v_mov_b32 v127, v111
    v_mul_f32 v115, s54, v111
    v_fma_f32 v110, v110, s54, -v115
    v_exp_f32 v110, v110
    s_nop 0
    v_cvt_pk_bf16_f32 v111, v110, v110
    ds_write_b16 v122, v111
    ds_read_b128 v[116:119], v123
    v_lshlrev_b32 v110, 16, v111
    s_nop 1
    v_add_f32_dpp v110, v110, v110 row_ror:8 row_mask:0xf bank_mask:0xf
    s_nop 1
    v_add_f32_dpp v110, v110, v110 row_ror:4 row_mask:0xf bank_mask:0xf
    s_nop 1
    v_add_f32_dpp v110, v110, v110 row_ror:2 row_mask:0xf bank_mask:0xf
    s_nop 1
    v_add_f32_dpp v110, v110, v110 row_ror:1 row_mask:0xf bank_mask:0xf
    s_nop 0
    v_mov_b32 v112, v110
    s_nop 1
    v_permlane16_swap_b32 v110, v112
    s_nop 1
    v_add_f32 v125, v110, v112
    s_waitcnt lgkmcnt(0)
    v_perm_b32 v42, v116, v116, v102
    v_perm_b32 v43, v116, v116, v103
    v_perm_b32 v44, v116, v116, v104
    v_perm_b32 v45, v116, v116, v105
    v_perm_b32 v46, v116, v116, v106
    v_perm_b32 v47, v116, v116, v107
    v_perm_b32 v48, v116, v116, v108
    v_perm_b32 v49, v116, v116, v109
    v_perm_b32 v50, v117, v117, v102
    v_perm_b32 v51, v117, v117, v103
    v_perm_b32 v52, v117, v117, v104
    v_perm_b32 v53, v117, v117, v105
    v_perm_b32 v54, v117, v117, v106
    v_perm_b32 v55, v117, v117, v107
    v_perm_b32 v56, v117, v117, v108
    v_perm_b32 v57, v117, v117, v109
    v_perm_b32 v58, v118, v118, v102
    v_perm_b32 v59, v118, v118, v103
    v_perm_b32 v60, v118, v118, v104
    v_perm_b32 v61, v118, v118, v105
    v_perm_b32 v62, v118, v118, v106
    v_perm_b32 v63, v118, v118, v107
    v_perm_b32 v64, v118, v118, v108
    v_perm_b32 v65, v118, v118, v109
    v_perm_b32 v66, v119, v119, v102
    v_perm_b32 v67, v119, v119, v103
    v_perm_b32 v68, v119, v119, v104
    v_perm_b32 v69, v119, v119, v105
    v_perm_b32 v70, v119, v119, v106
    v_perm_b32 v71, v119, v119, v107
    v_perm_b32 v72, v119, v119, v108
    v_perm_b32 v73, v119, v119, v109
    s_add_u32 s51, s49, 3
    s_and_b32 s51, s51, 7
    s_lshl_b32 s51, s51, 10
    s_add_u32 s51, s51, s48
    buffer_load_dwordx4 v[22:25], v4, s[24:27], s51 offen nt
    s_add_u32 s51, s49, 4
    s_and_b32 s51, s51, 7
    s_lshl_b32 s51, s51, 10
    s_add_u32 s51, s51, s48
    buffer_load_dwordx4 v[26:29], v4, s[24:27], s51 offen nt
    s_add_u32 s51, s49, 5
    s_and_b32 s51, s51, 7
    s_lshl_b32 s51, s51, 10
    s_add_u32 s51, s51, s48
    buffer_load_dwordx4 v[30:33], v4, s[24:27], s51 offen nt
    s_add_u32 s51, s49, 6
    s_and_b32 s51, s51, 7
    s_lshl_b32 s51, s51, 10
    s_add_u32 s51, s51, s48
    buffer_load_dwordx4 v[34:37], v4, s[24:27], s51 offen nt
    s_add_u32 s51, s49, 7
    s_and_b32 s51, s51, 7
    s_lshl_b32 s51, s51, 10
    s_add_u32 s51, s51, s48
    buffer_load_dwordx4 v[38:41], v4, s[24:27], s51 offen nt
    v_mov_b32 v114, 1
    v_mov_b32 v113, 0
    s_mov_b64 exec, 1
    ds_add_u32 v113, v114 offset:28
    s_mov_b64 exec, -1
    s_lshl_b32 s51, s44, 4
    s_add_u32 s51, s51, s45
    s_lshl_b32 s52, s51, 10
    s_add_u32 s52, s52, 65536
    s_sub_u32 s53, s3, 9
    s_lshl_b32 s51, s53, 9
    s_add_u32 s52, s52, s51
    v_bfe_u32 v1, v0, 3, 1
    v_lshlrev_b32 v104, 8, v1
    v_and_b32 v1, 7, v0
    v_lshl_add_u32 v104, v1, 5, v104
    v_bfe_u32 v105, v0, 4, 1
    v_lshl_add_u32 v104, v105, 4, v104
    v_add_u32 v104, s52, v104
    v_lshrrev_b32 v1, 5, v0
    v_lshlrev_b32 v103, 13, v1
    v_and_b32 v1, 31, v0
    v_lshl_add_u32 v103, v1, 4, v103
    s_add_u32 s51, s51, 29184
    v_add_u32 v103, s51, v103
    s_lshl_b32 s51, s44, 4
    s_lshl_b32 s52, s3, 2
    s_add_u32 s51, s51, s52
    v_add_u32 v112, s51, v3
    v_lshlrev_b32 v110, 10, v112
    v_lshl_add_u32 v110, v2, 4, v110
    s_lshl_b32 s51, s46, 8
    s_add_u32 s51, s51, 65536
    v_add_u32 v110, s51, v110
    v_add_u32 v113, s52, v3
    v_mul_u32_u24 v117, 144, v113
    v_lshl_add_u32 v117, v2, 3, v117
    v_lshlrev_b32 v118, 3, v113
    v_lshl_add_u32 v118, v2, 2, v118
    v_mul_u32_u24 v1, 144, v2
    v_lshl_add_u32 v119, v3, 4, v1
    v_lshrrev_b32 v120, 2, v2
    v_lshl_add_u32 v120, v3, 3, v120
    v_mul_u32_u24 v120, 288, v120
    v_and_b32 v1, 3, v0
    v_lshl_add_u32 v120, v1, 3, v120
    s_lshl_b32 s51, s3, 5
    s_add_u32 s51, s51, 10752
    v_add_u32 v120, s51, v120
    v_lshlrev_b32 v121, 5, v3
    s_mul_i32 s51, s47, 294912
    s_lshl_b32 s52, s3, 13
    s_add_u32 s51, s51, s52
    s_lshl_b32 s52, s63, 7
    s_add_u32 s51, s51, s52
    s_add_u32 s51, s51, 1114112
    v_mul_u32_u24 v1, 73728, v3
    v_lshl_add_u32 v1, v2, 4, v1
    v_add_u32 v122, s51, v1
    v_mov_b32 v1, 0
    s_mov_b32 s53, 0
L_cnt2:
    ds_read_b32 v126, v1 offset:28
    s_add_u32 s53, s53, 1
    s_waitcnt lgkmcnt(0)
    v_readfirstlane_b32 s51, v126
    s_cmp_ge_u32 s53, 800000
    s_cbranch_scc1 L_cnt2_ok
    s_cmp_lt_u32 s51, 16
    s_cbranch_scc1 L_cnt2
L_cnt2_ok:
    s_lshl_b32 s51, s44, 8
    s_lshl_b32 s52, s46, 6
    s_add_u32 s51, s51, s52
    s_lshl_b32 s52, s3, 2
    s_add_u32 s51, s51, s52
    s_mul_i32 s51, s51, 1152
    s_mul_i32 s52, s47, 288
    s_add_u32 s51, s51, s52
    s_mul_i32 s52, s3, 1152
    s_add_u32 m0, s52, 10752
    s_mov_b32 exec_lo, -1
    s_mov_b32 exec_hi, 0xf
    buffer_load_dwordx4 v124, s[32:35], s51 offen nt lds
    s_add_u32 s51, s51, 2304
    s_add_u32 m0, m0, 576
    s_nop 0
    buffer_load_dwordx4 v124, s[32:35], s51 offen nt lds
    s_mov_b64 exec, -1
    s_cmp_lt_u32 s3, 9
    s_cbranch_scc0 L_nopl
    s_mov_b32 exec_lo, 0x00010001
    s_mov_b32 exec_hi, 0x00010001
    global_load_dword v9, v122, s[18:19]
    s_mov_b64 exec, -1
L_nopl:
    v_lshrrev_b32 v1, 5, v0
    v_lshlrev_b32 v126, 2, v1
    v_lshlrev_b32 v1, 6, v1
    ds_read_b128 v[74:77], v1 offset:5120
    ds_read_b128 v[78:81], v1 offset:5136
    ds_read_b128 v[82:85], v1 offset:5152
    ds_read_b128 v[86:89], v1 offset:5168
    s_waitcnt lgkmcnt(0)
    v_max3_f32 v74, v74, v75, v76
    v_max3_f32 v77, v77, v78, v79
    v_max3_f32 v80, v80, v81, v82
    v_max3_f32 v83, v83, v84, v85
    v_max3_f32 v86, v86, v87, v88
    v_max3_f32 v74, v74, v77, v80
    v_max3_f32 v83, v83, v86, v89
    v_max_f32 v74, v74, v83
    v_sub_f32 v75, v127, v74
    v_mul_f32 v75, s54, v75
    v_exp_f32 v75, v75
    s_nop 0
    v_mul_f32 v76, v75, v125
    s_mov_b32 exec_lo, 1
    s_mov_b32 exec_hi, 1
    ds_write_b32 v126, v74 offset:0
    ds_add_f32 v126, v76 offset:8
    s_mov_b64 exec, -1
    s_cmp_lt_u32 s3, 9
    s_cbranch_scc0 L_pv2
    s_waitcnt vmcnt(10)
    v_mfma_f32_16x16x32_bf16 v[98:101], v[42:45], v[10:13], v[98:101]
    s_waitcnt vmcnt(9)
    v_mfma_f32_16x16x32_bf16 v[98:101], v[46:49], v[14:17], v[98:101]
    s_waitcnt vmcnt(8)
    v_mfma_f32_16x16x32_bf16 v[98:101], v[50:53], v[18:21], v[98:101]
    s_waitcnt vmcnt(7)
    v_mfma_f32_16x16x32_bf16 v[98:101], v[54:57], v[22:25], v[98:101]
    s_waitcnt vmcnt(6)
    v_mfma_f32_16x16x32_bf16 v[98:101], v[58:61], v[26:29], v[98:101]
    s_waitcnt vmcnt(5)
    v_mfma_f32_16x16x32_bf16 v[98:101], v[62:65], v[30:33], v[98:101]
    s_waitcnt vmcnt(4)
    v_mfma_f32_16x16x32_bf16 v[98:101], v[66:69], v[34:37], v[98:101]
    s_waitcnt vmcnt(3)
    v_mfma_f32_16x16x32_bf16 v[98:101], v[70:73], v[38:41], v[98:101]
    s_branch L_pvdone
L_pv2:
    s_waitcnt vmcnt(9)
    v_mfma_f32_16x16x32_bf16 v[98:101], v[42:45], v[10:13], v[98:101]
    s_waitcnt vmcnt(8)
    v_mfma_f32_16x16x32_bf16 v[98:101], v[46:49], v[14:17], v[98:101]
    s_waitcnt vmcnt(7)
    v_mfma_f32_16x16x32_bf16 v[98:101], v[50:53], v[18:21], v[98:101]
    s_waitcnt vmcnt(6)
    v_mfma_f32_16x16x32_bf16 v[98:101], v[54:57], v[22:25], v[98:101]
    s_waitcnt vmcnt(5)
    v_mfma_f32_16x16x32_bf16 v[98:101], v[58:61], v[26:29], v[98:101]
    s_waitcnt vmcnt(4)
    v_mfma_f32_16x16x32_bf16 v[98:101], v[62:65], v[30:33], v[98:101]
    s_waitcnt vmcnt(3)
    v_mfma_f32_16x16x32_bf16 v[98:101], v[66:69], v[34:37], v[98:101]
    s_waitcnt vmcnt(2)
    v_mfma_f32_16x16x32_bf16 v[98:101], v[70:73], v[38:41], v[98:101]
L_pvdone:
    s_lshl_b32 s51, s3, 10
    s_add_u32 s51, s51, 29184
    v_add_u32 v1, s51, v4
    s_nop 4
    v_mul_f32 v98, v75, v98
    v_mul_f32 v99, v75, v99
    v_mul_f32 v100, v75, v100
    v_mul_f32 v101, v75, v101
    ds_write_b128 v1, v[98:101]
    s_waitcnt lgkmcnt(0)
    s_barrier
    s_sub_u32 s51, s3, 9
    s_cmp_lt_u32 s51, 2
    s_cbranch_scc0 L_nopub
    ds_read_b128 v[42:45], v103 offset:0
    ds_read_b128 v[46:49], v103 offset:1024
    ds_read_b128 v[50:53], v103 offset:2048
    ds_read_b128 v[54:57], v103 offset:3072
    ds_read_b128 v[58:61], v103 offset:4096
    ds_read_b128 v[62:65], v103 offset:5120
    ds_read_b128 v[66:69], v103 offset:6144
    ds_read_b128 v[70:73], v103 offset:7168
    s_lshl_b32 s52, s51, 2
    v_mov_b32 v1, s52
    ds_read_b32 v86, v1 offset:0
    ds_read_b32 v87, v1 offset:8
    v_mov_b32 v92, s50
    v_cmp_eq_u32 vcc, 1, v105
    s_waitcnt lgkmcnt(6)
    v_pk_add_f32 v[42:43], v[42:43], v[46:47]
    v_pk_add_f32 v[44:45], v[44:45], v[48:49]
    v_pk_add_f32 v[50:51], v[50:51], v[54:55]
    v_pk_add_f32 v[52:53], v[52:53], v[56:57]
    s_waitcnt lgkmcnt(2)
    v_pk_add_f32 v[58:59], v[58:59], v[62:63]
    v_pk_add_f32 v[60:61], v[60:61], v[64:65]
    v_pk_add_f32 v[66:67], v[66:67], v[70:71]
    v_pk_add_f32 v[68:69], v[68:69], v[72:73]
    v_pk_add_f32 v[42:43], v[42:43], v[50:51]
    v_pk_add_f32 v[44:45], v[44:45], v[52:53]
    v_pk_add_f32 v[58:59], v[58:59], v[66:67]
    v_pk_add_f32 v[60:61], v[60:61], v[68:69]
    v_pk_add_f32 v[42:43], v[42:43], v[58:59]
    v_pk_add_f32 v[44:45], v[44:45], v[60:61]
    s_waitcnt lgkmcnt(0)
    v_mul_f32 v86, s54, v86
    v_mov_b32 v46, v42
    v_mov_b32 v47, v43
    v_mov_b32 v48, v44
    v_mov_b32 v49, v45
    v_cndmask_b32 v93, v86, v87, vcc
    v_permlane32_swap_b32 v42, v46
    v_permlane32_swap_b32 v43, v47
    v_permlane32_swap_b32 v44, v48
    v_permlane32_swap_b32 v45, v49
    s_nop 1
    v_add_f32 v42, v42, v46
    v_add_f32 v43, v43, v47
    v_add_f32 v44, v44, v48
    v_add_f32 v45, v45, v49
    v_cvt_pk_bf16_f32 v90, v42, v43
    v_cvt_pk_bf16_f32 v91, v44, v45
    s_mov_b32 exec_hi, 0
    s_cmp_eq_u32 s17, 1
    s_cbranch_scc1 L_oplain
    global_store_dwordx4 v104, v[90:93], s[18:19] sc1
    s_branch L_ostored
L_oplain:
    global_store_dwordx4 v104, v[90:93], s[18:19]
L_ostored:
    s_mov_b64 exec, -1
    s_barrier
    s_branch L_wowait
L_nopub:
    s_barrier
    s_cmp_lt_u32 s3, 9
    s_cbranch_scc0 L_wowait
    v_mov_b32 v66, 0
    v_mov_b32 v67, 0
    v_mov_b32 v68, 0
    v_mov_b32 v69, 0
    v_mov_b32 v74, s50
    v_mov_b32 v75, s50
    s_cmp_lt_u32 s3, 4
    s_cbranch_scc0 L_wowait
    s_mov_b32 s53, 0
L_opoll:
    global_load_dwordx4 v[42:45], v110, s[18:19] sc1
    s_add_u32 s53, s53, 1
    s_waitcnt vmcnt(0)
    v_cmp_eq_u32 vcc, s50, v44
    s_cmp_ge_u32 s53, 100000
    s_cbranch_scc1 L_ook
    s_cmp_eq_u64 vcc, -1
    s_cbranch_scc0 L_opoll
L_ook:
    ds_write_b64 v117, v[42:43] offset:2816
    s_mov_b32 exec_lo, 0x00030003
    s_mov_b32 exec_hi, 0x00030003
    ds_write_b32 v118, v45 offset:64
    s_mov_b64 exec, -1
L_wowait:
    s_waitcnt vmcnt(0) lgkmcnt(0)
    s_barrier
    s_cmp_lt_u32 s3, 9
    s_cbranch_scc0 L_notproj
    ds_read_b128 v[58:61], v121 offset:64
    ds_read_b128 v[62:65], v121 offset:80
    ds_read_b128 v[42:45], v119 offset:2816
    ds_read_b64_tr_b16 v[50:51], v120
    ds_read_b64_tr_b16 v[52:53], v120 offset:1152
    ds_read_b128 v[46:49], v119 offset:2880
    ds_read_b64_tr_b16 v[54:55], v120 offset:9216
    ds_read_b64_tr_b16 v[56:57], v120 offset:10368
    s_waitcnt lgkmcnt(3)
    v_mfma_f32_16x16x32_bf16 v[66:69], v[42:45], v[50:53], v[66:69]
    s_waitcnt lgkmcnt(0)
    v_mfma_f32_16x16x32_bf16 v[66:69], v[46:49], v[54:57], v[66:69]
    v_max3_f32 v70, v58, v60, v62
    v_max_f32 v70, v70, v64
    v_sub_f32 v58, v58, v70
    v_sub_f32 v60, v60, v70
    v_sub_f32 v62, v62, v70
    v_sub_f32 v64, v64, v70
    v_exp_f32 v58, v58
    v_exp_f32 v60, v60
    v_exp_f32 v62, v62
    v_exp_f32 v64, v64
    s_nop 0
    v_mul_f32 v71, v58, v59
    v_fmac_f32 v71, v60, v61
    v_fmac_f32 v71, v62, v63
    v_fmac_f32 v71, v64, v65
    v_rcp_f32 v71, v71
    v_mul_f32 v72, v58, v66
    v_fmac_f32 v72, v60, v67
    v_fmac_f32 v72, v62, v68
    v_fmac_f32 v72, v64, v69
    v_mul_f32 v72, v72, v71
    s_nop 1
    v_mov_b32_dpp v73, v72 row_ror:8 row_mask:0xf bank_mask:0xf
    s_mov_b32 exec_lo, 0x00ff00ff
    s_mov_b32 exec_hi, 0x00ff00ff
    global_store_dwordx4 v122, v[72:75], s[18:19] sc1
    s_mov_b64 exec, -1
    s_branch L_fin
L_notproj:
    s_cmp_ge_u32 s3, 12
    s_cbranch_scc0 L_fin
    s_cmp_lt_u32 s2, 144
    s_cbranch_scc0 L_fin
    s_and_b32 s51, s2, 3
    s_bfe_u32 s52, s2, 0x20002
    s_lshr_b32 s53, s2, 4
    s_lshl_b32 s60, s51, 2
    s_add_u32 s60, s60, s52
    s_mul_i32 s60, s60, 9
    s_add_u32 s60, s60, s53
    s_lshl_b32 s60, s60, 13
    s_add_u32 s60, s60, 1114112
    v_add_u32 v110, s60, v4
    v_add_u32 v112, 4096, v110
    s_mul_i32 s52, s52, 1152
    s_mul_i32 s51, s51, 288
    s_add_u32 s52, s52, s51
    s_lshl_b32 s53, s53, 5
    s_add_u32 s52, s52, s53
    v_lshlrev_b32 v111, 1, v0
    v_add_u32 v111, s52, v111
    s_sub_u32 s54, s3, 12
    s_lshl_b32 s51, s54, 11
    v_add_u32 v110, s51, v110
    s_mov_b32 s53, 0
L_r4poll:
    global_load_dwordx4 v[42:45], v110, s[18:19] sc1
    global_load_dwordx4 v[46:49], v110, s[18:19] offset:1024 sc1
    s_add_u32 s53, s53, 1
    s_cmp_ge_u32 s53, 100000
    s_waitcnt vmcnt(0)
    s_cbranch_scc1 L_r4ok
    v_cmp_ne_u32 vcc, s50, v44
    v_cmp_ne_u32 s[58:59], s50, v48
    s_nop 0
    s_or_b64 vcc, vcc, s[58:59]
    s_cmp_lg_u64 vcc, 0
    s_cbranch_scc1 L_r4poll
L_r4ok:
    v_pk_add_f32 v[42:43], v[42:43], v[46:47]
    s_lshl_b32 s51, s54, 6
    v_lshlrev_b32 v1, 3, v0
    v_add_u32 v113, s51, v1
    v_add_f32_dpp v42, v42, v42 row_ror:8 row_mask:0xf bank_mask:0xf
    v_add_f32_dpp v43, v43, v43 row_ror:8 row_mask:0xf bank_mask:0xf
    s_nop 0
    v_mov_b32 v44, v42
    v_mov_b32 v45, v43
    s_nop 0
    v_permlane16_swap_b32 v42, v44
    v_permlane16_swap_b32 v43, v45
    s_nop 0
    v_add_f32 v42, v42, v44
    v_add_f32 v43, v43, v45
    s_nop 0
    v_mov_b32 v44, v42
    v_mov_b32 v45, v43
    s_nop 0
    v_permlane32_swap_b32 v42, v44
    v_permlane32_swap_b32 v43, v45
    s_nop 0
    v_add_f32 v42, v42, v44
    v_add_f32 v43, v43, v45
    s_mov_b64 exec, 0xff
    ds_write_b64 v113, v[42:43] offset:768
    s_mov_b64 exec, -1
    s_waitcnt lgkmcnt(0)
    s_barrier
    s_cmp_eq_u32 s3, 12
    s_cbranch_scc0 L_fin
    v_and_b32 v1, 7, v0
    v_lshlrev_b32 v1, 3, v1
    ds_read_b64 v[42:43], v1 offset:768
    ds_read_b64 v[46:47], v1 offset:832
    ds_read_b64 v[48:49], v1 offset:896
    ds_read_b64 v[50:51], v1 offset:960
    s_cmp_eq_u32 s2, 0
    s_cbranch_scc0 L_r4noep
    v_mov_b32 v77, 0
    v_mov_b32 v76, s50
    s_mov_b64 exec, 1
    global_store_dword v77, v76, s[18:19]
    s_mov_b64 exec, -1
L_r4noep:
    s_waitcnt lgkmcnt(2)
    v_pk_add_f32 v[42:43], v[42:43], v[46:47]
    s_waitcnt lgkmcnt(0)
    v_pk_add_f32 v[48:49], v[48:49], v[50:51]
    s_nop 0
    v_pk_add_f32 v[42:43], v[42:43], v[48:49]
    s_nop 1
    v_mov_b32_dpp v44, v42 quad_perm:[1,0,3,2] row_mask:0xf bank_mask:0xf
    v_mov_b32_dpp v45, v43 quad_perm:[1,0,3,2] row_mask:0xf bank_mask:0xf
    s_nop 0
    v_cvt_pk_bf16_f32 v42, v42, v44
    v_cvt_pk_bf16_f32 v43, v43, v45
    s_mov_b64 exec, 0x55
    buffer_store_dword v42, v111, s[40:43], 0 offen
    buffer_store_dword v43, v111, s[40:43], 0 offen offset:16
    s_mov_b64 exec, -1
    s_branch L_fin
L_fin:
L_end:
    s_endpgm
.section .rodata,"a"
.p2align 6
.amdhsa_kernel standalone__sliding_block_cached__decode_kernel
  .amdhsa_next_free_vgpr 128
  .amdhsa_next_free_sgpr 100
  .amdhsa_accum_offset 128
  .amdhsa_group_segment_fixed_size 0
  .amdhsa_kernarg_size 64
  .amdhsa_user_sgpr_count 2
  .amdhsa_user_sgpr_kernarg_segment_ptr 1
  .amdhsa_system_sgpr_workgroup_id_x 1
.end_amdhsa_kernel
```
